```python
import torch

def _softmax(x, axis=-1):
    return torch.softmax(x, dim=axis)
def _gelu(x):
    return torch.nn.functional.gelu(x, approximate="tanh")
def _silu(x):
    return torch.nn.functional.silu(x)
def _sigmoid(x):
    return torch.sigmoid(x)
def _layernorm(x, axis=-1, eps=1e-5):
    m = x.mean(dim=axis, keepdim=True)
    v = x.var(dim=axis, keepdim=True, unbiased=False)
    return (x - m) / torch.sqrt(v + eps)
def _scatter_add(tgt, idx, src, axis=0):
    return tgt.clone().index_add_(axis, idx, src)
def _segment_sum(src, seg, n):
    out = torch.zeros((n,) + src.shape[1:], dtype=src.dtype)
    return out.index_add_(0, seg, src)
def _pad(x, pw):
    flat = tuple(v for pair in reversed(pw) for v in pair)
    return torch.nn.functional.pad(x, flat)

kernel_name = 'standalone__structured_sparse_n_m__ragged'

def setup_inputs():

    _w = (lambda a: (lambda t: t.to(torch.bfloat16) if t.is_floating_point() else t)(torch.as_tensor(a)))
    B, S, D = 16, 512, 1024
    assert D % 4 == 0, "d_model must be divisible by M=4 for 2:4 sparsity"
    return {
        "x": _w((lambda *s: torch.randn(*s, dtype=torch.bfloat16) * 0.05)(B, S, D)),
        "w": _w((lambda *s: torch.randn(*s, dtype=torch.bfloat16) * 0.05)(D, D)),
        "b": _w((lambda *s: torch.randn(*s, dtype=torch.bfloat16) * 0.05)(D)),
    }

def reference(x, w, b):
    B, S, D = x.shape
    N, M = 2, 4
    G = D // M
    wg = w.reshape(G, M, D)
    mag = torch.abs(wg)
    order = torch.argsort(mag, 1)
    thr = (lambda x, i, axis: torch.take_along_dim(x, i, dim=axis))(mag, order[:, M - N:M - N + 1, :], 1)
    mask = (lambda x, dt: x.to(dt))(mag >= thr, w.dtype)
    wp = (wg * mask).reshape(D, D)
    return torch.einsum("bsd,df->bsf", x, wp) + b
```

```asm
; @launch grid=(256,1,1) block=(512,1,1) lds=147456
.amdgcn_target "amdgcn-amd-amdhsa--gfx950"
.text
.globl standalone__structured_sparse_n_m__ragged_kernel
.p2align 8
.type standalone__structured_sparse_n_m__ragged_kernel,@function
standalone__structured_sparse_n_m__ragged_kernel:
  s_cmp_ge_u32 s2, 256
  s_cbranch_scc1 L_end
  s_load_dwordx8 s[4:11], s[0:1], 0
  v_lshrrev_b32 v1, 6, v0
  v_and_b32 v2, 63, v0
  s_and_b32 s32, s2, 7
  v_readfirstlane_b32 s3, v1
  s_lshr_b32 s33, s2, 3
  s_lshl_b32 s32, s32, 2
  s_lshr_b32 s40, s33, 3
  s_add_u32 s32, s32, s40
  s_and_b32 s33, s33, 7
  s_mov_b32 s37, 0x1000000
  s_mov_b32 s38, 0x200000
  s_mov_b32 s39, s3
  s_mov_b32 s28, 0
  s_lshl_b32 s29, s28, 10
  s_waitcnt lgkmcnt(0)
  s_mov_b32 s12, s4
  s_and_b32 s13, s5, 0xffff
  s_mov_b32 s14, 0x1000000
  s_mov_b32 s15, 0x00020000
  s_mov_b32 s16, s6
  s_and_b32 s17, s7, 0xffff
  s_mov_b32 s18, 0x200000
  s_mov_b32 s19, 0x00020000
  s_mov_b32 s20, s8
  s_and_b32 s21, s9, 0xffff
  s_mov_b32 s22, 0x800
  s_mov_b32 s23, 0x00020000
  s_mov_b32 s24, s10
  s_and_b32 s25, s11, 0xffff
  s_mov_b32 s26, 0x1000000
  s_mov_b32 s27, 0x00020000
  s_and_b32 s40, s3, 3
  s_lshr_b32 s48, s3, 2
  s_mov_b32 s35, 0x7fff7fff
  s_mov_b32 s36, 0x000f000f
  v_lshrrev_b32 v21, 4, v2
  s_lshl_b32 s40, s40, 2
  v_add_u32 v20, s40, v21
  v_and_b32 v22, 15, v2
  v_lshlrev_b32 v23, 13, v20
  s_lshl_b32 s41, s33, 8
  v_lshl_add_u32 v24, v22, 4, s41
  v_add_u32 v12, v23, v24
  v_add_u32 v13, 0x1000, v12
  s_lshl_b32 s41, s48, 17
  s_add_u32 s29, s29, s41
  s_and_b32 s29, s29, 0x1fffff
  buffer_load_dwordx4 v[64:67], v12, s[16:19], s29 offen offset:0
  buffer_load_dwordx4 v[68:71], v12, s[16:19], s29 offen offset:2048
  buffer_load_dwordx4 v[72:75], v13, s[16:19], s29 offen offset:0
  buffer_load_dwordx4 v[76:79], v13, s[16:19], s29 offen offset:2048
  v_lshlrev_b32 v23, 10, v20
  v_and_b32 v24, 3, v22
  v_lshl_add_u32 v23, v24, 4, v23
  s_lshl_b32 s41, s48, 14
  v_add_u32 v23, s41, v23
  v_lshrrev_b32 v24, 2, v22
  v_xor_b32 v25, 0, v24
  v_lshl_add_u32 v25, v25, 6, v23
  v_add_u32 v26, 0, v25
  v_xor_b32 v25, 1, v24
  v_lshl_add_u32 v25, v25, 6, v23
  v_add_u32 v27, 256, v25
  v_xor_b32 v25, 2, v24
  v_lshl_add_u32 v25, v25, 6, v23
  v_add_u32 v28, 512, v25
  v_xor_b32 v25, 3, v24
  v_lshl_add_u32 v25, v25, 6, v23
  v_add_u32 v29, 768, v25
  s_lshl_b32 s40, s32, 8
  s_and_b32 s41, s3, 3
  s_lshl_b32 s41, s41, 6
  s_add_u32 s40, s40, s41
  v_lshrrev_b32 v20, 3, v2
  v_add_u32 v20, s40, v20
  v_lshlrev_b32 v20, 11, v20
  v_lshrrev_b32 v21, 4, v2
  v_and_b32 v22, 7, v2
  v_xor_b32 v23, v22, v21
  v_xor_b32 v24, 4, v23
  v_lshl_add_u32 v23, v23, 4, v20
  v_lshl_add_u32 v24, v24, 4, v20
  v_add_u32 v116, 0, v23
  v_add_u32 v117, 15360, v24
  v_add_u32 v118, 30720, v23
  v_add_u32 v119, 46080, v24
  v_add_u32 v120, 65536, v23
  v_add_u32 v121, 80896, v24
  v_add_u32 v122, 96256, v23
  v_add_u32 v123, 111616, v24
  s_cmp_ge_u32 s3, 4
  s_cbranch_scc1 L_producer
  s_setprio 2
  s_lshl_b32 s47, s3, 13
  s_add_u32 s47, s47, 49152
  s_mov_b32 s34, s47
  s_lshr_b32 s40, s3, 1
  s_and_b32 s41, s3, 1
  v_lshrrev_b32 v3, 5, v2
  s_lshl_b32 s42, s33, 8
  s_lshl_b32 s43, s41, 7
  s_add_u32 s42, s42, s43
  v_lshlrev_b32 v16, 3, v3
  v_add_u32 v16, s42, v16
  s_add_u32 m0, s34, 0
  s_nop 0
  buffer_load_dwordx4 v116, s[12:15], s28 offen offset:0 nt lds
  buffer_load_dwordx4 v117, s[12:15], s28 offen offset:1024 nt lds
  buffer_load_dwordx4 v118, s[12:15], s28 offen offset:2048 nt lds
  buffer_load_dwordx4 v119, s[12:15], s28 offen offset:3072 nt lds
  s_add_u32 m0, s34, 4096
  s_nop 0
  buffer_load_dwordx4 v120, s[12:15], s28 offen offset:0 nt lds
  buffer_load_dwordx4 v121, s[12:15], s28 offen offset:1024 nt lds
  buffer_load_dwordx4 v122, s[12:15], s28 offen offset:2048 nt lds
  buffer_load_dwordx4 v123, s[12:15], s28 offen offset:3072 nt lds
  s_add_u32 s28, s28, 128
  s_and_b32 s28, s28, 2047
  s_add_u32 s34, s34, 32768
  buffer_load_dwordx2 v[80:81], v16, s[20:23], 0 offen offset:0
  buffer_load_dwordx2 v[82:83], v16, s[20:23], 0 offen offset:16
  buffer_load_dwordx2 v[84:85], v16, s[20:23], 0 offen offset:32
  buffer_load_dwordx2 v[86:87], v16, s[20:23], 0 offen offset:48
  buffer_load_dwordx2 v[88:89], v16, s[20:23], 0 offen offset:64
  buffer_load_dwordx2 v[90:91], v16, s[20:23], 0 offen offset:80
  buffer_load_dwordx2 v[92:93], v16, s[20:23], 0 offen offset:96
  buffer_load_dwordx2 v[94:95], v16, s[20:23], 0 offen offset:112
  s_add_u32 m0, s34, 0
  s_nop 0
  buffer_load_dwordx4 v116, s[12:15], s28 offen offset:0 nt lds
  buffer_load_dwordx4 v117, s[12:15], s28 offen offset:1024 nt lds
  buffer_load_dwordx4 v118, s[12:15], s28 offen offset:2048 nt lds
  buffer_load_dwordx4 v119, s[12:15], s28 offen offset:3072 nt lds
  s_add_u32 m0, s34, 4096
  s_nop 0
  buffer_load_dwordx4 v120, s[12:15], s28 offen offset:0 nt lds
  buffer_load_dwordx4 v121, s[12:15], s28 offen offset:1024 nt lds
  buffer_load_dwordx4 v122, s[12:15], s28 offen offset:2048 nt lds
  buffer_load_dwordx4 v123, s[12:15], s28 offen offset:3072 nt lds
  s_add_u32 s28, s28, 128
  s_and_b32 s28, s28, 2047
  s_add_u32 s34, s34, 32768
  v_and_b32 v24, 31, v2
  v_bfe_u32 v25, v2, 1, 3
  s_lshl_b32 s42, s40, 14
  s_add_u32 s42, s42, 49152
  v_lshlrev_b32 v17, 7, v24
  v_add_u32 v17, s42, v17
  v_add_u32 v18, 0, v3
  v_xor_b32 v18, v18, v25
  v_lshl_add_u32 v8, v18, 4, v17
  v_mov_b32 v4, v8
  v_add_u32 v18, 2, v3
  v_xor_b32 v18, v18, v25
  v_lshl_add_u32 v9, v18, 4, v17
  v_mov_b32 v5, v9
  v_add_u32 v18, 4, v3
  v_xor_b32 v18, v18, v25
  v_lshl_add_u32 v10, v18, 4, v17
  v_mov_b32 v6, v10
  v_add_u32 v18, 6, v3
  v_xor_b32 v18, v18, v25
  v_lshl_add_u32 v11, v18, 4, v17
  v_mov_b32 v7, v11
  v_bfe_u32 v18, v2, 2, 2
  v_lshl_add_u32 v19, v3, 3, v18
  v_lshlrev_b32 v19, 8, v19
  v_bfe_u32 v20, v2, 4, 1
  v_lshl_add_u32 v19, v20, 5, v19
  v_and_b32 v20, 3, v2
  v_lshl_add_u32 v19, v20, 3, v19
  s_lshl_b32 s42, s41, 1
  s_add_u32 s43, s42, 0
  v_xor_b32 v20, s43, v18
  v_lshl_add_u32 v14, v20, 6, v19
  v_mov_b32 v12, v14
  s_add_u32 s43, s42, 1
  v_xor_b32 v20, s43, v18
  v_lshl_add_u32 v15, v20, 6, v19
  v_mov_b32 v13, v15
  s_lshl_b32 s42, s40, 15
  s_add_u32 s42, s42, 49152
  v_lshlrev_b32 v20, 8, v24
  v_add_u32 v20, s42, v20
  v_and_b32 v21, 7, v2
  s_lshl_b32 s42, s41, 3
  s_add_u32 s43, s42, 0
  v_add_u32 v22, s43, v3
  v_xor_b32 v22, v22, v21
  v_lshl_add_u32 v96, v22, 4, v20
  s_add_u32 s43, s42, 2
  v_add_u32 v22, s43, v3
  v_xor_b32 v22, v22, v21
  v_lshl_add_u32 v97, v22, 4, v20
  s_add_u32 s43, s42, 4
  v_add_u32 v22, s43, v3
  v_xor_b32 v22, v22, v21
  v_lshl_add_u32 v98, v22, 4, v20
  s_add_u32 s43, s42, 6
  v_add_u32 v22, s43, v3
  v_xor_b32 v22, v22, v21
  v_lshl_add_u32 v99, v22, 4, v20
  s_waitcnt vmcnt(24)
  s_branch L_prune0
L_cons2:
  s_waitcnt vmcnt(8)
  s_mov_b32 s42, 0xffff0000
  v_lshlrev_b32 v128, 16, v80
  v_and_b32 v129, s42, v80
  v_lshlrev_b32 v130, 16, v81
  v_and_b32 v131, s42, v81
  v_lshlrev_b32 v132, 16, v82
  v_and_b32 v133, s42, v82
  v_lshlrev_b32 v134, 16, v83
  v_and_b32 v135, s42, v83
  v_lshlrev_b32 v136, 16, v84
  v_and_b32 v137, s42, v84
  v_lshlrev_b32 v138, 16, v85
  v_and_b32 v139, s42, v85
  v_lshlrev_b32 v140, 16, v86
  v_and_b32 v141, s42, v86
  v_lshlrev_b32 v142, 16, v87
  v_and_b32 v143, s42, v87
  v_lshlrev_b32 v192, 16, v88
  v_and_b32 v193, s42, v88
  v_lshlrev_b32 v194, 16, v89
  v_and_b32 v195, s42, v89
  v_lshlrev_b32 v196, 16, v90
  v_and_b32 v197, s42, v90
  v_lshlrev_b32 v198, 16, v91
  v_and_b32 v199, s42, v91
  v_lshlrev_b32 v200, 16, v92
  v_and_b32 v201, s42, v92
  v_lshlrev_b32 v202, 16, v93
  v_and_b32 v203, s42, v93
  v_lshlrev_b32 v204, 16, v94
  v_and_b32 v205, s42, v94
  v_lshlrev_b32 v206, 16, v95
  v_and_b32 v207, s42, v95
  v_mov_b32 v144, v128
  v_mov_b32 v145, v129
  v_mov_b32 v146, v130
  v_mov_b32 v147, v131
  v_mov_b32 v148, v132
  v_mov_b32 v149, v133
  v_mov_b32 v150, v134
  v_mov_b32 v151, v135
  v_mov_b32 v152, v136
  v_mov_b32 v153, v137
  v_mov_b32 v154, v138
  v_mov_b32 v155, v139
  v_mov_b32 v156, v140
  v_mov_b32 v157, v141
  v_mov_b32 v158, v142
  v_mov_b32 v159, v143
  v_mov_b32 v160, v128
  v_mov_b32 v161, v129
  v_mov_b32 v162, v130
  v_mov_b32 v163, v131
  v_mov_b32 v164, v132
  v_mov_b32 v165, v133
  v_mov_b32 v166, v134
  v_mov_b32 v167, v135
  v_mov_b32 v168, v136
  v_mov_b32 v169, v137
  v_mov_b32 v170, v138
  v_mov_b32 v171, v139
  v_mov_b32 v172, v140
  v_mov_b32 v173, v141
  v_mov_b32 v174, v142
  v_mov_b32 v175, v143
  v_mov_b32 v176, v128
  v_mov_b32 v177, v129
  v_mov_b32 v178, v130
  v_mov_b32 v179, v131
  v_mov_b32 v180, v132
  v_mov_b32 v181, v133
  v_mov_b32 v182, v134
  v_mov_b32 v183, v135
  v_mov_b32 v184, v136
  v_mov_b32 v185, v137
  v_mov_b32 v186, v138
  v_mov_b32 v187, v139
  v_mov_b32 v188, v140
  v_mov_b32 v189, v141
  v_mov_b32 v190, v142
  v_mov_b32 v191, v143
  v_mov_b32 v208, v192
  v_mov_b32 v209, v193
  v_mov_b32 v210, v194
  v_mov_b32 v211, v195
  v_mov_b32 v212, v196
  v_mov_b32 v213, v197
  v_mov_b32 v214, v198
  v_mov_b32 v215, v199
  v_mov_b32 v216, v200
  v_mov_b32 v217, v201
  v_mov_b32 v218, v202
  v_mov_b32 v219, v203
  v_mov_b32 v220, v204
  v_mov_b32 v221, v205
  v_mov_b32 v222, v206
  v_mov_b32 v223, v207
  v_mov_b32 v224, v192
  v_mov_b32 v225, v193
  v_mov_b32 v226, v194
  v_mov_b32 v227, v195
  v_mov_b32 v228, v196
  v_mov_b32 v229, v197
  v_mov_b32 v230, v198
  v_mov_b32 v231, v199
  v_mov_b32 v232, v200
  v_mov_b32 v233, v201
  v_mov_b32 v234, v202
  v_mov_b32 v235, v203
  v_mov_b32 v236, v204
  v_mov_b32 v237, v205
  v_mov_b32 v238, v206
  v_mov_b32 v239, v207
  v_mov_b32 v240, v192
  v_mov_b32 v241, v193
  v_mov_b32 v242, v194
  v_mov_b32 v243, v195
  v_mov_b32 v244, v196
  v_mov_b32 v245, v197
  v_mov_b32 v246, v198
  v_mov_b32 v247, v199
  v_mov_b32 v248, v200
  v_mov_b32 v249, v201
  v_mov_b32 v250, v202
  v_mov_b32 v251, v203
  v_mov_b32 v252, v204
  v_mov_b32 v253, v205
  v_mov_b32 v254, v206
  v_mov_b32 v255, v207
  s_waitcnt lgkmcnt(0)
  v_mov_b32 v56, 0
  v_mov_b32 v57, 0
  v_mov_b32 v58, 0
  v_mov_b32 v59, 0
  v_mov_b32 v60, 0
  v_mov_b32 v61, 0
  v_mov_b32 v62, 0
  v_mov_b32 v63, 0
  v_mov_b32 v64, 0
  v_mov_b32 v65, 0
  v_mov_b32 v66, 0
  v_mov_b32 v67, 0
  v_mov_b32 v68, 0
  v_mov_b32 v69, 0
  v_mov_b32 v70, 0
  v_mov_b32 v71, 0
  v_mov_b32 v72, 0
  v_mov_b32 v73, 0
  v_mov_b32 v74, 0
  v_mov_b32 v75, 0
  v_mov_b32 v76, 0
  v_mov_b32 v77, 0
  v_mov_b32 v78, 0
  v_mov_b32 v79, 0
  s_mov_b32 s31, 0
  s_mov_b32 s44, 0
  s_mov_b32 s45, 65536
  s_waitcnt lgkmcnt(0)
  s_barrier
L_cloop:
  v_mfma_f32_32x32x16_bf16 v[128:143], v[72:75], v[56:59], v[128:143]
  ds_read_b64_tr_b16 v[48:49], v12 offset:0
  ds_read_b64_tr_b16 v[50:51], v12 offset:1024
  v_mfma_f32_32x32x16_bf16 v[144:159], v[72:75], v[60:63], v[144:159]
  ds_read_b128 v[32:35], v4 offset:0
  ds_read_b128 v[36:39], v4 offset:4096
  v_mfma_f32_32x32x16_bf16 v[160:175], v[72:75], v[64:67], v[160:175]
  ds_read_b128 v[40:43], v4 offset:8192
  ds_read_b128 v[44:47], v4 offset:12288
  v_mfma_f32_32x32x16_bf16 v[176:191], v[72:75], v[68:71], v[176:191]
  ds_read_b64_tr_b16 v[52:53], v13 offset:0
  ds_read_b64_tr_b16 v[54:55], v13 offset:1024
  s_cmp_lt_u32 s31, 14
  s_cselect_b32 s14, s37, 0
  s_add_u32 s34, s47, s45
  v_mfma_f32_32x32x16_bf16 v[192:207], v[76:79], v[56:59], v[192:207]
  s_add_u32 m0, s34, 0
  s_nop 0
  buffer_load_dwordx4 v116, s[12:15], s28 offen offset:0 nt lds
  v_mfma_f32_32x32x16_bf16 v[208:223], v[76:79], v[60:63], v[208:223]
  v_mfma_f32_32x32x16_bf16 v[224:239], v[76:79], v[64:67], v[224:239]
  buffer_load_dwordx4 v117, s[12:15], s28 offen offset:1024 nt lds
  v_mfma_f32_32x32x16_bf16 v[240:255], v[76:79], v[68:71], v[240:255]
  s_waitcnt lgkmcnt(0)
  v_mfma_f32_32x32x16_bf16 v[128:143], v[48:51], v[32:35], v[128:143]
  ds_read_b64_tr_b16 v[72:73], v12 offset:4096
  ds_read_b64_tr_b16 v[74:75], v12 offset:5120
  v_mfma_f32_32x32x16_bf16 v[144:159], v[48:51], v[36:39], v[144:159]
  ds_read_b128 v[56:59], v5 offset:0
  ds_read_b128 v[60:63], v5 offset:4096
  v_mfma_f32_32x32x16_bf16 v[160:175], v[48:51], v[40:43], v[160:175]
  ds_read_b128 v[64:67], v5 offset:8192
  ds_read_b128 v[68:71], v5 offset:12288
  v_mfma_f32_32x32x16_bf16 v[176:191], v[48:51], v[44:47], v[176:191]
  ds_read_b64_tr_b16 v[76:77], v13 offset:4096
  ds_read_b64_tr_b16 v[78:79], v13 offset:5120
  v_mfma_f32_32x32x16_bf16 v[192:207], v[52:55], v[32:35], v[192:207]
  buffer_load_dwordx4 v118, s[12:15], s28 offen offset:2048 nt lds
  v_mfma_f32_32x32x16_bf16 v[208:223], v[52:55], v[36:39], v[208:223]
  v_mfma_f32_32x32x16_bf16 v[224:239], v[52:55], v[40:43], v[224:239]
  buffer_load_dwordx4 v119, s[12:15], s28 offen offset:3072 nt lds
  v_mfma_f32_32x32x16_bf16 v[240:255], v[52:55], v[44:47], v[240:255]
  s_waitcnt lgkmcnt(0)
  v_mfma_f32_32x32x16_bf16 v[128:143], v[72:75], v[56:59], v[128:143]
  ds_read_b64_tr_b16 v[48:49], v12 offset:8192
  ds_read_b64_tr_b16 v[50:51], v12 offset:9216
  v_mfma_f32_32x32x16_bf16 v[144:159], v[72:75], v[60:63], v[144:159]
  ds_read_b128 v[32:35], v6 offset:0
  ds_read_b128 v[36:39], v6 offset:4096
  v_mfma_f32_32x32x16_bf16 v[160:175], v[72:75], v[64:67], v[160:175]
  ds_read_b128 v[40:43], v6 offset:8192
  ds_read_b128 v[44:47], v6 offset:12288
  v_mfma_f32_32x32x16_bf16 v[176:191], v[72:75], v[68:71], v[176:191]
  ds_read_b64_tr_b16 v[52:53], v13 offset:8192
  ds_read_b64_tr_b16 v[54:55], v13 offset:9216
  v_mfma_f32_32x32x16_bf16 v[192:207], v[76:79], v[56:59], v[192:207]
  s_add_u32 m0, s34, 4096
  s_nop 0
  buffer_load_dwordx4 v120, s[12:15], s28 offen offset:0 nt lds
  v_mfma_f32_32x32x16_bf16 v[208:223], v[76:79], v[60:63], v[208:223]
  s_add_u32 s44, s44, 16384
  s_cmp_eq_u32 s44, 49152
  s_cselect_b32 s44, 0, s44
  s_lshl_b32 s46, s44, 1
  v_mfma_f32_32x32x16_bf16 v[224:239], v[76:79], v[64:67], v[224:239]
  buffer_load_dwordx4 v121, s[12:15], s28 offen offset:1024 nt lds
  v_mfma_f32_32x32x16_bf16 v[240:255], v[76:79], v[68:71], v[240:255]
  s_add_u32 s45, s45, 32768
  s_cmp_eq_u32 s45, 98304
  s_cselect_b32 s45, 0, s45
  s_waitcnt lgkmcnt(0)
  v_mfma_f32_32x32x16_bf16 v[128:143], v[48:51], v[32:35], v[128:143]
  ds_read_b64_tr_b16 v[72:73], v12 offset:12288
  ds_read_b64_tr_b16 v[74:75], v12 offset:13312
  v_mfma_f32_32x32x16_bf16 v[144:159], v[48:51], v[36:39], v[144:159]
  ds_read_b128 v[56:59], v7 offset:0
  ds_read_b128 v[60:63], v7 offset:4096
  v_mfma_f32_32x32x16_bf16 v[160:175], v[48:51], v[40:43], v[160:175]
  ds_read_b128 v[64:67], v7 offset:8192
  ds_read_b128 v[68:71], v7 offset:12288
  v_mfma_f32_32x32x16_bf16 v[176:191], v[48:51], v[44:47], v[176:191]
  ds_read_b64_tr_b16 v[76:77], v13 offset:12288
  ds_read_b64_tr_b16 v[78:79], v13 offset:13312
  v_mfma_f32_32x32x16_bf16 v[192:207], v[52:55], v[32:35], v[192:207]
  buffer_load_dwordx4 v122, s[12:15], s28 offen offset:2048 nt lds
  v_add_u32 v4, s46, v8
  v_add_u32 v5, s46, v9
  v_add_u32 v6, s46, v10
  v_mfma_f32_32x32x16_bf16 v[208:223], v[52:55], v[36:39], v[208:223]
  v_add_u32 v7, s46, v11
  v_add_u32 v12, s44, v14
  v_add_u32 v13, s44, v15
  v_mfma_f32_32x32x16_bf16 v[224:239], v[52:55], v[40:43], v[224:239]
  buffer_load_dwordx4 v123, s[12:15], s28 offen offset:3072 nt lds
  s_add_u32 s28, s28, 128
  s_and_b32 s28, s28, 2047
  v_mfma_f32_32x32x16_bf16 v[240:255], v[52:55], v[44:47], v[240:255]
  s_add_u32 s31, s31, 1
  s_cmp_lt_u32 s31, 16
  s_cbranch_scc1 L_cnodrain
  s_waitcnt vmcnt(0)
L_cnodrain:
  s_waitcnt vmcnt(8) lgkmcnt(0)
  s_barrier
  s_cbranch_scc1 L_cloop
  v_mfma_f32_32x32x16_bf16 v[128:143], v[72:75], v[56:59], v[128:143]
  v_mfma_f32_32x32x16_bf16 v[192:207], v[76:79], v[56:59], v[192:207]
  v_mfma_f32_32x32x16_bf16 v[144:159], v[72:75], v[60:63], v[144:159]
  s_nop 9
  v_cvt_pk_bf16_f32 v100, v128, v129
  v_cvt_pk_bf16_f32 v101, v130, v131
  v_cvt_pk_bf16_f32 v102, v132, v133
  v_cvt_pk_bf16_f32 v103, v134, v135
  v_cvt_pk_bf16_f32 v104, v136, v137
  v_cvt_pk_bf16_f32 v105, v138, v139
  v_cvt_pk_bf16_f32 v106, v140, v141
  v_cvt_pk_bf16_f32 v107, v142, v143
  s_nop 1
  v_permlane32_swap_b32 v100, v102
  v_permlane32_swap_b32 v101, v103
  v_permlane32_swap_b32 v104, v106
  v_permlane32_swap_b32 v105, v107
  ds_write_b128 v96, v[100:103] offset:0
  ds_write_b128 v97, v[104:107] offset:0
  v_mfma_f32_32x32x16_bf16 v[208:223], v[76:79], v[60:63], v[208:223]
  v_cvt_pk_bf16_f32 v108, v192, v193
  v_cvt_pk_bf16_f32 v109, v194, v195
  v_cvt_pk_bf16_f32 v110, v196, v197
  v_cvt_pk_bf16_f32 v111, v198, v199
  v_cvt_pk_bf16_f32 v112, v200, v201
  v_cvt_pk_bf16_f32 v113, v202, v203
  v_cvt_pk_bf16_f32 v114, v204, v205
  v_cvt_pk_bf16_f32 v115, v206, v207
  s_nop 1
  v_permlane32_swap_b32 v108, v110
  v_permlane32_swap_b32 v109, v111
  v_permlane32_swap_b32 v112, v114
  v_permlane32_swap_b32 v113, v115
  ds_write_b128 v98, v[108:111] offset:0
  ds_write_b128 v99, v[112:115] offset:0
  v_mfma_f32_32x32x16_bf16 v[160:175], v[72:75], v[64:67], v[160:175]
  v_cvt_pk_bf16_f32 v100, v144, v145
  v_cvt_pk_bf16_f32 v101, v146, v147
  v_cvt_pk_bf16_f32 v102, v148, v149
  v_cvt_pk_bf16_f32 v103, v150, v151
  v_cvt_pk_bf16_f32 v104, v152, v153
  v_cvt_pk_bf16_f32 v105, v154, v155
  v_cvt_pk_bf16_f32 v106, v156, v157
  v_cvt_pk_bf16_f32 v107, v158, v159
  s_nop 1
  v_permlane32_swap_b32 v100, v102
  v_permlane32_swap_b32 v101, v103
  v_permlane32_swap_b32 v104, v106
  v_permlane32_swap_b32 v105, v107
  ds_write_b128 v96, v[100:103] offset:8192
  ds_write_b128 v97, v[104:107] offset:8192
  v_mfma_f32_32x32x16_bf16 v[224:239], v[76:79], v[64:67], v[224:239]
  v_cvt_pk_bf16_f32 v108, v208, v209
  v_cvt_pk_bf16_f32 v109, v210, v211
  v_cvt_pk_bf16_f32 v110, v212, v213
  v_cvt_pk_bf16_f32 v111, v214, v215
  v_cvt_pk_bf16_f32 v112, v216, v217
  v_cvt_pk_bf16_f32 v113, v218, v219
  v_cvt_pk_bf16_f32 v114, v220, v221
  v_cvt_pk_bf16_f32 v115, v222, v223
  s_nop 1
  v_permlane32_swap_b32 v108, v110
  v_permlane32_swap_b32 v109, v111
  v_permlane32_swap_b32 v112, v114
  v_permlane32_swap_b32 v113, v115
  ds_write_b128 v98, v[108:111] offset:8192
  ds_write_b128 v99, v[112:115] offset:8192
  s_waitcnt lgkmcnt(0)
  s_barrier
  v_mfma_f32_32x32x16_bf16 v[176:191], v[72:75], v[68:71], v[176:191]
  v_cvt_pk_bf16_f32 v100, v160, v161
  v_cvt_pk_bf16_f32 v101, v162, v163
  v_cvt_pk_bf16_f32 v102, v164, v165
  v_cvt_pk_bf16_f32 v103, v166, v167
  v_cvt_pk_bf16_f32 v104, v168, v169
  v_cvt_pk_bf16_f32 v105, v170, v171
  v_cvt_pk_bf16_f32 v106, v172, v173
  v_cvt_pk_bf16_f32 v107, v174, v175
  s_nop 1
  v_permlane32_swap_b32 v100, v102
  v_permlane32_swap_b32 v101, v103
  v_permlane32_swap_b32 v104, v106
  v_permlane32_swap_b32 v105, v107
  ds_write_b128 v96, v[100:103] offset:16384
  ds_write_b128 v97, v[104:107] offset:16384
  v_mfma_f32_32x32x16_bf16 v[240:255], v[76:79], v[68:71], v[240:255]
  v_cvt_pk_bf16_f32 v108, v224, v225
  v_cvt_pk_bf16_f32 v109, v226, v227
  v_cvt_pk_bf16_f32 v110, v228, v229
  v_cvt_pk_bf16_f32 v111, v230, v231
  v_cvt_pk_bf16_f32 v112, v232, v233
  v_cvt_pk_bf16_f32 v113, v234, v235
  v_cvt_pk_bf16_f32 v114, v236, v237
  v_cvt_pk_bf16_f32 v115, v238, v239
  s_nop 1
  v_permlane32_swap_b32 v108, v110
  v_permlane32_swap_b32 v109, v111
  v_permlane32_swap_b32 v112, v114
  v_permlane32_swap_b32 v113, v115
  ds_write_b128 v98, v[108:111] offset:16384
  ds_write_b128 v99, v[112:115] offset:16384
  s_nop 15
  v_cvt_pk_bf16_f32 v100, v176, v177
  v_cvt_pk_bf16_f32 v101, v178, v179
  v_cvt_pk_bf16_f32 v102, v180, v181
  v_cvt_pk_bf16_f32 v103, v182, v183
  v_cvt_pk_bf16_f32 v104, v184, v185
  v_cvt_pk_bf16_f32 v105, v186, v187
  v_cvt_pk_bf16_f32 v106, v188, v189
  v_cvt_pk_bf16_f32 v107, v190, v191
  s_nop 1
  v_permlane32_swap_b32 v100, v102
  v_permlane32_swap_b32 v101, v103
  v_permlane32_swap_b32 v104, v106
  v_permlane32_swap_b32 v105, v107
  ds_write_b128 v96, v[100:103] offset:24576
  ds_write_b128 v97, v[104:107] offset:24576
  s_nop 7
  v_cvt_pk_bf16_f32 v108, v240, v241
  v_cvt_pk_bf16_f32 v109, v242, v243
  v_cvt_pk_bf16_f32 v110, v244, v245
  v_cvt_pk_bf16_f32 v111, v246, v247
  v_cvt_pk_bf16_f32 v112, v248, v249
  v_cvt_pk_bf16_f32 v113, v250, v251
  v_cvt_pk_bf16_f32 v114, v252, v253
  v_cvt_pk_bf16_f32 v115, v254, v255
  s_nop 1
  v_permlane32_swap_b32 v108, v110
  v_permlane32_swap_b32 v109, v111
  v_permlane32_swap_b32 v112, v114
  v_permlane32_swap_b32 v113, v115
  ds_write_b128 v98, v[108:111] offset:24576
  ds_write_b128 v99, v[112:115] offset:24576
  s_branch L_store
L_producer:
  s_add_u32 s29, s29, 0x20000
  s_and_b32 s29, s29, 0x1fffff
  buffer_load_dwordx4 v[80:83], v12, s[16:19], s29 offen offset:0
  buffer_load_dwordx4 v[84:87], v12, s[16:19], s29 offen offset:2048
  buffer_load_dwordx4 v[88:91], v13, s[16:19], s29 offen offset:0
  buffer_load_dwordx4 v[92:95], v13, s[16:19], s29 offen offset:2048
  s_add_u32 s29, s29, 0x20000
  s_and_b32 s29, s29, 0x1fffff
  buffer_load_dwordx4 v[96:99], v12, s[16:19], s29 offen offset:0
  buffer_load_dwordx4 v[100:103], v12, s[16:19], s29 offen offset:2048
  buffer_load_dwordx4 v[104:107], v13, s[16:19], s29 offen offset:0
  buffer_load_dwordx4 v[108:111], v13, s[16:19], s29 offen offset:2048
  s_add_u32 s29, s29, 0x20000
  s_and_b32 s29, s29, 0x1fffff
  v_subrev_u32 v4, 16384, v26
  v_subrev_u32 v5, 16384, v27
  v_subrev_u32 v6, 16384, v28
  v_subrev_u32 v7, 16384, v29
  s_waitcnt vmcnt(8)
L_prune0:
  v_and_b32 v32, s35, v64
  v_and_b32 v40, s35, v65
  v_and_b32 v33, s35, v68
  v_and_b32 v41, s35, v69
  v_and_b32 v34, s35, v72
  v_and_b32 v42, s35, v73
  v_and_b32 v35, s35, v76
  v_and_b32 v43, s35, v77
  v_pk_max_u16 v36, v32, v33
  v_pk_max_u16 v44, v40, v41
  v_pk_min_u16 v37, v32, v33
  v_pk_min_u16 v45, v40, v41
  v_pk_max_u16 v38, v34, v35
  v_pk_max_u16 v46, v42, v43
  v_pk_min_u16 v39, v34, v35
  v_pk_min_u16 v47, v42, v43
  v_pk_min_u16 v36, v36, v38
  v_pk_min_u16 v44, v44, v46
  v_pk_max_u16 v37, v37, v39
  v_pk_max_u16 v45, v45, v47
  v_pk_max_u16 v36, v36, v37
  v_pk_max_u16 v44, v44, v45
  v_pk_sub_i16 v32, v32, v36
  v_pk_sub_i16 v40, v40, v44
  v_pk_sub_i16 v33, v33, v36
  v_pk_sub_i16 v41, v41, v44
  v_pk_sub_i16 v34, v34, v36
  v_pk_sub_i16 v42, v42, v44
  v_pk_sub_i16 v35, v35, v36
  v_pk_sub_i16 v43, v43, v44
  v_pk_ashrrev_i16 v32, s36, v32
  v_pk_ashrrev_i16 v40, s36, v40
  v_pk_ashrrev_i16 v33, s36, v33
  v_pk_ashrrev_i16 v41, s36, v41
  v_pk_ashrrev_i16 v34, s36, v34
  v_pk_ashrrev_i16 v42, s36, v42
  v_pk_ashrrev_i16 v35, s36, v35
  v_pk_ashrrev_i16 v43, s36, v43
  v_bfi_b32 v64, v32, 0, v64
  v_bfi_b32 v65, v40, 0, v65
  v_bfi_b32 v68, v33, 0, v68
  v_bfi_b32 v69, v41, 0, v69
  v_bfi_b32 v72, v34, 0, v72
  v_bfi_b32 v73, v42, 0, v73
  v_bfi_b32 v76, v35, 0, v76
  v_bfi_b32 v77, v43, 0, v77
  v_and_b32 v32, s35, v66
  v_and_b32 v40, s35, v67
  v_and_b32 v33, s35, v70
  v_and_b32 v41, s35, v71
  v_and_b32 v34, s35, v74
  v_and_b32 v42, s35, v75
  v_and_b32 v35, s35, v78
  v_and_b32 v43, s35, v79
  v_pk_max_u16 v36, v32, v33
  v_pk_max_u16 v44, v40, v41
  v_pk_min_u16 v37, v32, v33
  v_pk_min_u16 v45, v40, v41
  v_pk_max_u16 v38, v34, v35
  v_pk_max_u16 v46, v42, v43
  v_pk_min_u16 v39, v34, v35
  v_pk_min_u16 v47, v42, v43
  v_pk_min_u16 v36, v36, v38
  v_pk_min_u16 v44, v44, v46
  v_pk_max_u16 v37, v37, v39
  v_pk_max_u16 v45, v45, v47
  v_pk_max_u16 v36, v36, v37
  v_pk_max_u16 v44, v44, v45
  v_pk_sub_i16 v32, v32, v36
  v_pk_sub_i16 v40, v40, v44
  v_pk_sub_i16 v33, v33, v36
  v_pk_sub_i16 v41, v41, v44
  v_pk_sub_i16 v34, v34, v36
  v_pk_sub_i16 v42, v42, v44
  v_pk_sub_i16 v35, v35, v36
  v_pk_sub_i16 v43, v43, v44
  v_pk_ashrrev_i16 v32, s36, v32
  v_pk_ashrrev_i16 v40, s36, v40
  v_pk_ashrrev_i16 v33, s36, v33
  v_pk_ashrrev_i16 v41, s36, v41
  v_pk_ashrrev_i16 v34, s36, v34
  v_pk_ashrrev_i16 v42, s36, v42
  v_pk_ashrrev_i16 v35, s36, v35
  v_pk_ashrrev_i16 v43, s36, v43
  v_bfi_b32 v66, v32, 0, v66
  v_bfi_b32 v67, v40, 0, v67
  v_bfi_b32 v70, v33, 0, v70
  v_bfi_b32 v71, v41, 0, v71
  v_bfi_b32 v74, v34, 0, v74
  v_bfi_b32 v75, v42, 0, v75
  v_bfi_b32 v78, v35, 0, v78
  v_bfi_b32 v79, v43, 0, v79
  ds_write_b128 v26, v[64:67]
  ds_write_b128 v27, v[68:71]
  ds_write_b128 v28, v[72:75]
  ds_write_b128 v29, v[76:79]
  s_cmp_lt_u32 s3, 4
  s_cbranch_scc1 L_cons2
  s_mov_b32 s30, 0
  s_mov_b32 s31, 0
  s_mov_b32 s44, 32768
  s_barrier
L_ploop:
  s_cmp_lt_u32 s31, 12
  s_cselect_b32 s18, s38, 0
  s_add_u32 s31, s31, 1
  v_add_u32 v14, s44, v4
  v_add_u32 v15, s44, v5
  v_add_u32 v16, s44, v6
  v_add_u32 v17, s44, v7
  s_add_u32 s44, s44, 16384
  s_cmp_eq_u32 s44, 49152
  s_cselect_b32 s44, 0, s44
  s_waitcnt vmcnt(4)
  buffer_load_dwordx4 v[48:51], v12, s[16:19], s29 offen offset:0
  v_and_b32 v32, s35, v80
  v_and_b32 v40, s35, v81
  v_and_b32 v33, s35, v84
  v_and_b32 v41, s35, v85
  v_and_b32 v34, s35, v88
  v_and_b32 v42, s35, v89
  v_and_b32 v35, s35, v92
  v_and_b32 v43, s35, v93
  v_pk_max_u16 v36, v32, v33
  v_pk_max_u16 v44, v40, v41
  v_pk_min_u16 v37, v32, v33
  v_pk_min_u16 v45, v40, v41
  v_pk_max_u16 v38, v34, v35
  v_pk_max_u16 v46, v42, v43
  v_pk_min_u16 v39, v34, v35
  v_pk_min_u16 v47, v42, v43
  v_pk_min_u16 v36, v36, v38
  v_pk_min_u16 v44, v44, v46
  v_pk_max_u16 v37, v37, v39
  v_pk_max_u16 v45, v45, v47
  v_pk_max_u16 v36, v36, v37
  v_pk_max_u16 v44, v44, v45
  v_pk_sub_i16 v32, v32, v36
  buffer_load_dwordx4 v[52:55], v12, s[16:19], s29 offen offset:2048
  v_pk_sub_i16 v40, v40, v44
  v_pk_sub_i16 v33, v33, v36
  v_pk_sub_i16 v41, v41, v44
  v_pk_sub_i16 v34, v34, v36
  v_pk_sub_i16 v42, v42, v44
  v_pk_sub_i16 v35, v35, v36
  v_pk_sub_i16 v43, v43, v44
  v_pk_ashrrev_i16 v32, s36, v32
  v_pk_ashrrev_i16 v40, s36, v40
  v_pk_ashrrev_i16 v33, s36, v33
  v_pk_ashrrev_i16 v41, s36, v41
  v_pk_ashrrev_i16 v34, s36, v34
  v_pk_ashrrev_i16 v42, s36, v42
  v_pk_ashrrev_i16 v35, s36, v35
  v_pk_ashrrev_i16 v43, s36, v43
  v_bfi_b32 v80, v32, 0, v80
  v_bfi_b32 v81, v40, 0, v81
  v_bfi_b32 v84, v33, 0, v84
  v_bfi_b32 v85, v41, 0, v85
  v_bfi_b32 v88, v34, 0, v88
  v_bfi_b32 v89, v42, 0, v89
  v_bfi_b32 v92, v35, 0, v92
  v_bfi_b32 v93, v43, 0, v93
  buffer_load_dwordx4 v[56:59], v13, s[16:19], s29 offen offset:0
  v_and_b32 v32, s35, v82
  v_and_b32 v40, s35, v83
  v_and_b32 v33, s35, v86
  v_and_b32 v41, s35, v87
  v_and_b32 v34, s35, v90
  v_and_b32 v42, s35, v91
  v_and_b32 v35, s35, v94
  v_and_b32 v43, s35, v95
  v_pk_max_u16 v36, v32, v33
  v_pk_max_u16 v44, v40, v41
  v_pk_min_u16 v37, v32, v33
  v_pk_min_u16 v45, v40, v41
  v_pk_max_u16 v38, v34, v35
  v_pk_max_u16 v46, v42, v43
  v_pk_min_u16 v39, v34, v35
  v_pk_min_u16 v47, v42, v43
  v_pk_min_u16 v36, v36, v38
  v_pk_min_u16 v44, v44, v46
  v_pk_max_u16 v37, v37, v39
  v_pk_max_u16 v45, v45, v47
  v_pk_max_u16 v36, v36, v37
  v_pk_max_u16 v44, v44, v45
  v_pk_sub_i16 v32, v32, v36
  buffer_load_dwordx4 v[60:63], v13, s[16:19], s29 offen offset:2048
  v_pk_sub_i16 v40, v40, v44
  v_pk_sub_i16 v33, v33, v36
  v_pk_sub_i16 v41, v41, v44
  v_pk_sub_i16 v34, v34, v36
  v_pk_sub_i16 v42, v42, v44
  v_pk_sub_i16 v35, v35, v36
  v_pk_sub_i16 v43, v43, v44
  v_pk_ashrrev_i16 v32, s36, v32
  v_pk_ashrrev_i16 v40, s36, v40
  v_pk_ashrrev_i16 v33, s36, v33
  v_pk_ashrrev_i16 v41, s36, v41
  v_pk_ashrrev_i16 v34, s36, v34
  v_pk_ashrrev_i16 v42, s36, v42
  v_pk_ashrrev_i16 v35, s36, v35
  v_pk_ashrrev_i16 v43, s36, v43
  v_bfi_b32 v82, v32, 0, v82
  v_bfi_b32 v83, v40, 0, v83
  v_bfi_b32 v86, v33, 0, v86
  v_bfi_b32 v87, v41, 0, v87
  v_bfi_b32 v90, v34, 0, v90
  v_bfi_b32 v91, v42, 0, v91
  v_bfi_b32 v94, v35, 0, v94
  v_bfi_b32 v95, v43, 0, v95
  ds_write_b128 v14, v[80:83] offset:0
  ds_write_b128 v15, v[84:87] offset:0
  ds_write_b128 v16, v[88:91] offset:0
  ds_write_b128 v17, v[92:95] offset:0
  s_add_u32 s29, s29, 0x20000
  s_and_b32 s29, s29, 0x1fffff
  s_waitcnt lgkmcnt(4)
  s_barrier
  s_cmp_lt_u32 s31, 12
  s_cselect_b32 s18, s38, 0
  s_add_u32 s31, s31, 1
  v_add_u32 v14, s44, v4
  v_add_u32 v15, s44, v5
  v_add_u32 v16, s44, v6
  v_add_u32 v17, s44, v7
  s_add_u32 s44, s44, 16384
  s_cmp_eq_u32 s44, 49152
  s_cselect_b32 s44, 0, s44
  s_waitcnt vmcnt(4)
  buffer_load_dwordx4 v[64:67], v12, s[16:19], s29 offen offset:0
  v_and_b32 v32, s35, v96
  v_and_b32 v40, s35, v97
  v_and_b32 v33, s35, v100
  v_and_b32 v41, s35, v101
  v_and_b32 v34, s35, v104
  v_and_b32 v42, s35, v105
  v_and_b32 v35, s35, v108
  v_and_b32 v43, s35, v109
  v_pk_max_u16 v36, v32, v33
  v_pk_max_u16 v44, v40, v41
  v_pk_min_u16 v37, v32, v33
  v_pk_min_u16 v45, v40, v41
  v_pk_max_u16 v38, v34, v35
  v_pk_max_u16 v46, v42, v43
  v_pk_min_u16 v39, v34, v35
  v_pk_min_u16 v47, v42, v43
  v_pk_min_u16 v36, v36, v38
  v_pk_min_u16 v44, v44, v46
  v_pk_max_u16 v37, v37, v39
  v_pk_max_u16 v45, v45, v47
  v_pk_max_u16 v36, v36, v37
  v_pk_max_u16 v44, v44, v45
  v_pk_sub_i16 v32, v32, v36
  buffer_load_dwordx4 v[68:71], v12, s[16:19], s29 offen offset:2048
  v_pk_sub_i16 v40, v40, v44
  v_pk_sub_i16 v33, v33, v36
  v_pk_sub_i16 v41, v41, v44
  v_pk_sub_i16 v34, v34, v36
  v_pk_sub_i16 v42, v42, v44
  v_pk_sub_i16 v35, v35, v36
  v_pk_sub_i16 v43, v43, v44
  v_pk_ashrrev_i16 v32, s36, v32
  v_pk_ashrrev_i16 v40, s36, v40
  v_pk_ashrrev_i16 v33, s36, v33
  v_pk_ashrrev_i16 v41, s36, v41
  v_pk_ashrrev_i16 v34, s36, v34
  v_pk_ashrrev_i16 v42, s36, v42
  v_pk_ashrrev_i16 v35, s36, v35
  v_pk_ashrrev_i16 v43, s36, v43
  v_bfi_b32 v96, v32, 0, v96
  v_bfi_b32 v97, v40, 0, v97
  v_bfi_b32 v100, v33, 0, v100
  v_bfi_b32 v101, v41, 0, v101
  v_bfi_b32 v104, v34, 0, v104
  v_bfi_b32 v105, v42, 0, v105
  v_bfi_b32 v108, v35, 0, v108
  v_bfi_b32 v109, v43, 0, v109
  buffer_load_dwordx4 v[72:75], v13, s[16:19], s29 offen offset:0
  v_and_b32 v32, s35, v98
  v_and_b32 v40, s35, v99
  v_and_b32 v33, s35, v102
  v_and_b32 v41, s35, v103
  v_and_b32 v34, s35, v106
  v_and_b32 v42, s35, v107
  v_and_b32 v35, s35, v110
  v_and_b32 v43, s35, v111
  v_pk_max_u16 v36, v32, v33
  v_pk_max_u16 v44, v40, v41
  v_pk_min_u16 v37, v32, v33
  v_pk_min_u16 v45, v40, v41
  v_pk_max_u16 v38, v34, v35
  v_pk_max_u16 v46, v42, v43
  v_pk_min_u16 v39, v34, v35
  v_pk_min_u16 v47, v42, v43
  v_pk_min_u16 v36, v36, v38
  v_pk_min_u16 v44, v44, v46
  v_pk_max_u16 v37, v37, v39
  v_pk_max_u16 v45, v45, v47
  v_pk_max_u16 v36, v36, v37
  v_pk_max_u16 v44, v44, v45
  v_pk_sub_i16 v32, v32, v36
  buffer_load_dwordx4 v[76:79], v13, s[16:19], s29 offen offset:2048
  v_pk_sub_i16 v40, v40, v44
  v_pk_sub_i16 v33, v33, v36
  v_pk_sub_i16 v41, v41, v44
  v_pk_sub_i16 v34, v34, v36
  v_pk_sub_i16 v42, v42, v44
  v_pk_sub_i16 v35, v35, v36
  v_pk_sub_i16 v43, v43, v44
  v_pk_ashrrev_i16 v32, s36, v32
  v_pk_ashrrev_i16 v40, s36, v40
  v_pk_ashrrev_i16 v33, s36, v33
  v_pk_ashrrev_i16 v41, s36, v41
  v_pk_ashrrev_i16 v34, s36, v34
  v_pk_ashrrev_i16 v42, s36, v42
  v_pk_ashrrev_i16 v35, s36, v35
  v_pk_ashrrev_i16 v43, s36, v43
  v_bfi_b32 v98, v32, 0, v98
  v_bfi_b32 v99, v40, 0, v99
  v_bfi_b32 v102, v33, 0, v102
  v_bfi_b32 v103, v41, 0, v103
  v_bfi_b32 v106, v34, 0, v106
  v_bfi_b32 v107, v42, 0, v107
  v_bfi_b32 v110, v35, 0, v110
  v_bfi_b32 v111, v43, 0, v111
  ds_write_b128 v14, v[96:99] offset:0
  ds_write_b128 v15, v[100:103] offset:0
  ds_write_b128 v16, v[104:107] offset:0
  ds_write_b128 v17, v[108:111] offset:0
  s_add_u32 s29, s29, 0x20000
  s_and_b32 s29, s29, 0x1fffff
  s_waitcnt lgkmcnt(4)
  s_barrier
  s_cmp_lt_u32 s31, 12
  s_cselect_b32 s18, s38, 0
  s_add_u32 s31, s31, 1
  v_add_u32 v14, s44, v4
  v_add_u32 v15, s44, v5
  v_add_u32 v16, s44, v6
  v_add_u32 v17, s44, v7
  s_add_u32 s44, s44, 16384
  s_cmp_eq_u32 s44, 49152
  s_cselect_b32 s44, 0, s44
  s_waitcnt vmcnt(4)
  buffer_load_dwordx4 v[80:83], v12, s[16:19], s29 offen offset:0
  v_and_b32 v32, s35, v48
  v_and_b32 v40, s35, v49
  v_and_b32 v33, s35, v52
  v_and_b32 v41, s35, v53
  v_and_b32 v34, s35, v56
  v_and_b32 v42, s35, v57
  v_and_b32 v35, s35, v60
  v_and_b32 v43, s35, v61
  v_pk_max_u16 v36, v32, v33
  v_pk_max_u16 v44, v40, v41
  v_pk_min_u16 v37, v32, v33
  v_pk_min_u16 v45, v40, v41
  v_pk_max_u16 v38, v34, v35
  v_pk_max_u16 v46, v42, v43
  v_pk_min_u16 v39, v34, v35
  v_pk_min_u16 v47, v42, v43
  v_pk_min_u16 v36, v36, v38
  v_pk_min_u16 v44, v44, v46
  v_pk_max_u16 v37, v37, v39
  v_pk_max_u16 v45, v45, v47
  v_pk_max_u16 v36, v36, v37
  v_pk_max_u16 v44, v44, v45
  v_pk_sub_i16 v32, v32, v36
  buffer_load_dwordx4 v[84:87], v12, s[16:19], s29 offen offset:2048
  v_pk_sub_i16 v40, v40, v44
  v_pk_sub_i16 v33, v33, v36
  v_pk_sub_i16 v41, v41, v44
  v_pk_sub_i16 v34, v34, v36
  v_pk_sub_i16 v42, v42, v44
  v_pk_sub_i16 v35, v35, v36
  v_pk_sub_i16 v43, v43, v44
  v_pk_ashrrev_i16 v32, s36, v32
  v_pk_ashrrev_i16 v40, s36, v40
  v_pk_ashrrev_i16 v33, s36, v33
  v_pk_ashrrev_i16 v41, s36, v41
  v_pk_ashrrev_i16 v34, s36, v34
  v_pk_ashrrev_i16 v42, s36, v42
  v_pk_ashrrev_i16 v35, s36, v35
  v_pk_ashrrev_i16 v43, s36, v43
  v_bfi_b32 v48, v32, 0, v48
  v_bfi_b32 v49, v40, 0, v49
  v_bfi_b32 v52, v33, 0, v52
  v_bfi_b32 v53, v41, 0, v53
  v_bfi_b32 v56, v34, 0, v56
  v_bfi_b32 v57, v42, 0, v57
  v_bfi_b32 v60, v35, 0, v60
  v_bfi_b32 v61, v43, 0, v61
  buffer_load_dwordx4 v[88:91], v13, s[16:19], s29 offen offset:0
  v_and_b32 v32, s35, v50
  v_and_b32 v40, s35, v51
  v_and_b32 v33, s35, v54
  v_and_b32 v41, s35, v55
  v_and_b32 v34, s35, v58
  v_and_b32 v42, s35, v59
  v_and_b32 v35, s35, v62
  v_and_b32 v43, s35, v63
  v_pk_max_u16 v36, v32, v33
  v_pk_max_u16 v44, v40, v41
  v_pk_min_u16 v37, v32, v33
  v_pk_min_u16 v45, v40, v41
  v_pk_max_u16 v38, v34, v35
  v_pk_max_u16 v46, v42, v43
  v_pk_min_u16 v39, v34, v35
  v_pk_min_u16 v47, v42, v43
  v_pk_min_u16 v36, v36, v38
  v_pk_min_u16 v44, v44, v46
  v_pk_max_u16 v37, v37, v39
  v_pk_max_u16 v45, v45, v47
  v_pk_max_u16 v36, v36, v37
  v_pk_max_u16 v44, v44, v45
  v_pk_sub_i16 v32, v32, v36
  buffer_load_dwordx4 v[92:95], v13, s[16:19], s29 offen offset:2048
  v_pk_sub_i16 v40, v40, v44
  v_pk_sub_i16 v33, v33, v36
  v_pk_sub_i16 v41, v41, v44
  v_pk_sub_i16 v34, v34, v36
  v_pk_sub_i16 v42, v42, v44
  v_pk_sub_i16 v35, v35, v36
  v_pk_sub_i16 v43, v43, v44
  v_pk_ashrrev_i16 v32, s36, v32
  v_pk_ashrrev_i16 v40, s36, v40
  v_pk_ashrrev_i16 v33, s36, v33
  v_pk_ashrrev_i16 v41, s36, v41
  v_pk_ashrrev_i16 v34, s36, v34
  v_pk_ashrrev_i16 v42, s36, v42
  v_pk_ashrrev_i16 v35, s36, v35
  v_pk_ashrrev_i16 v43, s36, v43
  v_bfi_b32 v50, v32, 0, v50
  v_bfi_b32 v51, v40, 0, v51
  v_bfi_b32 v54, v33, 0, v54
  v_bfi_b32 v55, v41, 0, v55
  v_bfi_b32 v58, v34, 0, v58
  v_bfi_b32 v59, v42, 0, v59
  v_bfi_b32 v62, v35, 0, v62
  v_bfi_b32 v63, v43, 0, v63
  ds_write_b128 v14, v[48:51] offset:0
  ds_write_b128 v15, v[52:55] offset:0
  ds_write_b128 v16, v[56:59] offset:0
  ds_write_b128 v17, v[60:63] offset:0
  s_add_u32 s29, s29, 0x20000
  s_and_b32 s29, s29, 0x1fffff
  s_waitcnt lgkmcnt(4)
  s_barrier
  s_cmp_lt_u32 s31, 12
  s_cselect_b32 s18, s38, 0
  s_add_u32 s31, s31, 1
  v_add_u32 v14, s44, v4
  v_add_u32 v15, s44, v5
  v_add_u32 v16, s44, v6
  v_add_u32 v17, s44, v7
  s_add_u32 s44, s44, 16384
  s_cmp_eq_u32 s44, 49152
  s_cselect_b32 s44, 0, s44
  s_waitcnt vmcnt(4)
  buffer_load_dwordx4 v[96:99], v12, s[16:19], s29 offen offset:0
  v_and_b32 v32, s35, v64
  v_and_b32 v40, s35, v65
  v_and_b32 v33, s35, v68
  v_and_b32 v41, s35, v69
  v_and_b32 v34, s35, v72
  v_and_b32 v42, s35, v73
  v_and_b32 v35, s35, v76
  v_and_b32 v43, s35, v77
  v_pk_max_u16 v36, v32, v33
  v_pk_max_u16 v44, v40, v41
  v_pk_min_u16 v37, v32, v33
  v_pk_min_u16 v45, v40, v41
  v_pk_max_u16 v38, v34, v35
  v_pk_max_u16 v46, v42, v43
  v_pk_min_u16 v39, v34, v35
  v_pk_min_u16 v47, v42, v43
  v_pk_min_u16 v36, v36, v38
  v_pk_min_u16 v44, v44, v46
  v_pk_max_u16 v37, v37, v39
  v_pk_max_u16 v45, v45, v47
  v_pk_max_u16 v36, v36, v37
  v_pk_max_u16 v44, v44, v45
  v_pk_sub_i16 v32, v32, v36
  buffer_load_dwordx4 v[100:103], v12, s[16:19], s29 offen offset:2048
  v_pk_sub_i16 v40, v40, v44
  v_pk_sub_i16 v33, v33, v36
  v_pk_sub_i16 v41, v41, v44
  v_pk_sub_i16 v34, v34, v36
  v_pk_sub_i16 v42, v42, v44
  v_pk_sub_i16 v35, v35, v36
  v_pk_sub_i16 v43, v43, v44
  v_pk_ashrrev_i16 v32, s36, v32
  v_pk_ashrrev_i16 v40, s36, v40
  v_pk_ashrrev_i16 v33, s36, v33
  v_pk_ashrrev_i16 v41, s36, v41
  v_pk_ashrrev_i16 v34, s36, v34
  v_pk_ashrrev_i16 v42, s36, v42
  v_pk_ashrrev_i16 v35, s36, v35
  v_pk_ashrrev_i16 v43, s36, v43
  v_bfi_b32 v64, v32, 0, v64
  v_bfi_b32 v65, v40, 0, v65
  v_bfi_b32 v68, v33, 0, v68
  v_bfi_b32 v69, v41, 0, v69
  v_bfi_b32 v72, v34, 0, v72
  v_bfi_b32 v73, v42, 0, v73
  v_bfi_b32 v76, v35, 0, v76
  v_bfi_b32 v77, v43, 0, v77
  buffer_load_dwordx4 v[104:107], v13, s[16:19], s29 offen offset:0
  v_and_b32 v32, s35, v66
  v_and_b32 v40, s35, v67
  v_and_b32 v33, s35, v70
  v_and_b32 v41, s35, v71
  v_and_b32 v34, s35, v74
  v_and_b32 v42, s35, v75
  v_and_b32 v35, s35, v78
  v_and_b32 v43, s35, v79
  v_pk_max_u16 v36, v32, v33
  v_pk_max_u16 v44, v40, v41
  v_pk_min_u16 v37, v32, v33
  v_pk_min_u16 v45, v40, v41
  v_pk_max_u16 v38, v34, v35
  v_pk_max_u16 v46, v42, v43
  v_pk_min_u16 v39, v34, v35
  v_pk_min_u16 v47, v42, v43
  v_pk_min_u16 v36, v36, v38
  v_pk_min_u16 v44, v44, v46
  v_pk_max_u16 v37, v37, v39
  v_pk_max_u16 v45, v45, v47
  v_pk_max_u16 v36, v36, v37
  v_pk_max_u16 v44, v44, v45
  v_pk_sub_i16 v32, v32, v36
  buffer_load_dwordx4 v[108:111], v13, s[16:19], s29 offen offset:2048
  v_pk_sub_i16 v40, v40, v44
  v_pk_sub_i16 v33, v33, v36
  v_pk_sub_i16 v41, v41, v44
  v_pk_sub_i16 v34, v34, v36
  v_pk_sub_i16 v42, v42, v44
  v_pk_sub_i16 v35, v35, v36
  v_pk_sub_i16 v43, v43, v44
  v_pk_ashrrev_i16 v32, s36, v32
  v_pk_ashrrev_i16 v40, s36, v40
  v_pk_ashrrev_i16 v33, s36, v33
  v_pk_ashrrev_i16 v41, s36, v41
  v_pk_ashrrev_i16 v34, s36, v34
  v_pk_ashrrev_i16 v42, s36, v42
  v_pk_ashrrev_i16 v35, s36, v35
  v_pk_ashrrev_i16 v43, s36, v43
  v_bfi_b32 v66, v32, 0, v66
  v_bfi_b32 v67, v40, 0, v67
  v_bfi_b32 v70, v33, 0, v70
  v_bfi_b32 v71, v41, 0, v71
  v_bfi_b32 v74, v34, 0, v74
  v_bfi_b32 v75, v42, 0, v75
  v_bfi_b32 v78, v35, 0, v78
  v_bfi_b32 v79, v43, 0, v79
  ds_write_b128 v14, v[64:67] offset:0
  ds_write_b128 v15, v[68:71] offset:0
  ds_write_b128 v16, v[72:75] offset:0
  ds_write_b128 v17, v[76:79] offset:0
  s_add_u32 s29, s29, 0x20000
  s_and_b32 s29, s29, 0x1fffff
  s_add_u32 s30, s30, 1
  s_cmp_lt_u32 s30, 4
  s_waitcnt lgkmcnt(4)
  s_barrier
  s_cbranch_scc1 L_ploop
  s_waitcnt vmcnt(0) lgkmcnt(0)
  s_and_b32 s40, s39, 3
  s_lshr_b32 s43, s40, 1
  s_lshl_b32 s43, s43, 7
  s_and_b32 s40, s40, 1
  s_lshl_b32 s40, s40, 5
  s_add_u32 s40, s40, s43
  v_lshrrev_b32 v16, 4, v2
  v_and_b32 v17, 15, v2
  v_add_u32 v18, s40, v16
  v_xor_b32 v19, v17, v16
  v_xor_b32 v20, 4, v19
  v_lshlrev_b32 v21, 8, v18
  v_add_u32 v21, 49152, v21
  v_lshl_add_u32 v19, v19, 4, v21
  v_lshl_add_u32 v20, v20, 4, v21
  s_lshl_b32 s41, s32, 8
  v_add_u32 v18, s41, v18
  v_lshlrev_b32 v18, 11, v18
  s_lshl_b32 s41, s33, 8
  v_lshl_add_u32 v21, v17, 4, s41
  v_add_u32 v18, v18, v21
  s_barrier
  ds_read_b128 v[32:35], v19 offset:0
  ds_read_b128 v[36:39], v20 offset:1024
  ds_read_b128 v[40:43], v19 offset:2048
  ds_read_b128 v[44:47], v20 offset:3072
  ds_read_b128 v[48:51], v19 offset:4096
  ds_read_b128 v[52:55], v20 offset:5120
  ds_read_b128 v[56:59], v19 offset:6144
  ds_read_b128 v[60:63], v20 offset:7168
  s_mov_b32 s42, 0
  s_waitcnt lgkmcnt(7)
  buffer_store_dwordx4 v[32:35], v18, s[24:27], s42 offen nt
  s_mov_b32 s42, 8192
  s_waitcnt lgkmcnt(6)
  buffer_store_dwordx4 v[36:39], v18, s[24:27], s42 offen nt
  s_mov_b32 s42, 16384
  s_waitcnt lgkmcnt(5)
  buffer_store_dwordx4 v[40:43], v18, s[24:27], s42 offen nt
  s_mov_b32 s42, 24576
  s_waitcnt lgkmcnt(4)
  buffer_store_dwordx4 v[44:47], v18, s[24:27], s42 offen nt
  s_mov_b32 s42, 32768
  s_waitcnt lgkmcnt(3)
  buffer_store_dwordx4 v[48:51], v18, s[24:27], s42 offen nt
  s_mov_b32 s42, 40960
  s_waitcnt lgkmcnt(2)
  buffer_store_dwordx4 v[52:55], v18, s[24:27], s42 offen nt
  s_mov_b32 s42, 49152
  s_waitcnt lgkmcnt(1)
  buffer_store_dwordx4 v[56:59], v18, s[24:27], s42 offen nt
  s_mov_b32 s42, 57344
  s_waitcnt lgkmcnt(0)
  buffer_store_dwordx4 v[60:63], v18, s[24:27], s42 offen nt
L_store:
  s_lshr_b32 s43, s39, 2
  s_lshl_b32 s43, s43, 7
  s_and_b32 s40, s39, 3
  s_lshl_b32 s40, s40, 4
  s_add_u32 s40, s40, s43
  s_add_u32 s40, s40, 64
  v_lshrrev_b32 v16, 4, v2
  v_and_b32 v17, 15, v2
  v_add_u32 v18, s40, v16
  v_xor_b32 v19, v17, v16
  v_xor_b32 v20, 4, v19
  v_lshlrev_b32 v21, 8, v18
  v_add_u32 v21, 49152, v21
  v_lshl_add_u32 v19, v19, 4, v21
  v_lshl_add_u32 v20, v20, 4, v21
  s_lshl_b32 s41, s32, 8
  v_add_u32 v18, s41, v18
  v_lshlrev_b32 v18, 11, v18
  s_lshl_b32 s41, s33, 8
  v_lshl_add_u32 v21, v17, 4, s41
  v_add_u32 v18, v18, v21
  s_waitcnt lgkmcnt(0)
  s_barrier
  ds_read_b128 v[64:67], v19 offset:0
  ds_read_b128 v[68:71], v20 offset:1024
  ds_read_b128 v[72:75], v19 offset:2048
  ds_read_b128 v[76:79], v20 offset:3072
  s_mov_b32 s42, 0
  s_waitcnt lgkmcnt(3)
  buffer_store_dwordx4 v[64:67], v18, s[24:27], s42 offen nt
  s_mov_b32 s42, 8192
  s_waitcnt lgkmcnt(2)
  buffer_store_dwordx4 v[68:71], v18, s[24:27], s42 offen nt
  s_mov_b32 s42, 16384
  s_waitcnt lgkmcnt(1)
  buffer_store_dwordx4 v[72:75], v18, s[24:27], s42 offen nt
  s_mov_b32 s42, 24576
  s_waitcnt lgkmcnt(0)
  buffer_store_dwordx4 v[76:79], v18, s[24:27], s42 offen nt
L_end:
  s_endpgm

.section .rodata,"a"
.p2align 6
.amdhsa_kernel standalone__structured_sparse_n_m__ragged_kernel
  .amdhsa_next_free_vgpr 256
  .amdhsa_next_free_sgpr 64
  .amdhsa_accum_offset 256
  .amdhsa_group_segment_fixed_size 0
  .amdhsa_kernarg_size 48
  .amdhsa_user_sgpr_count 2
  .amdhsa_user_sgpr_kernarg_segment_ptr 1
  .amdhsa_system_sgpr_workgroup_id_x 1
.end_amdhsa_kernel
```
